```python
import torch

def _softmax(x, axis=-1):
    return torch.softmax(x, dim=axis)
def _gelu(x):
    return torch.nn.functional.gelu(x, approximate="tanh")
def _silu(x):
    return torch.nn.functional.silu(x)
def _sigmoid(x):
    return torch.sigmoid(x)
def _layernorm(x, axis=-1, eps=1e-5):
    m = x.mean(dim=axis, keepdim=True)
    v = x.var(dim=axis, keepdim=True, unbiased=False)
    return (x - m) / torch.sqrt(v + eps)
def _scatter_add(tgt, idx, src, axis=0):
    return tgt.clone().index_add_(axis, idx, src)
def _segment_sum(src, seg, n):
    out = torch.zeros((n,) + src.shape[1:], dtype=src.dtype)
    return out.index_add_(0, seg, src)
def _pad(x, pw):
    flat = tuple(v for pair in reversed(pw) for v in pair)
    return torch.nn.functional.pad(x, flat)

kernel_name = 'standalone__mha_softmax__decode'

def setup_inputs():

    _w = (lambda a: (lambda t: t.to(torch.bfloat16) if t.is_floating_point() else t)(torch.as_tensor(a)))
    B, H, Sq, Sk, D = 2, 32, 1, 4096, 128
    return {
        "q": _w((lambda *s: torch.randn(*s, dtype=torch.bfloat16) * 0.8)(B, H, Sq, D)),
        "k": _w((lambda *s: torch.randn(*s, dtype=torch.bfloat16) * 0.8)(B, H, Sk, D)),
        "v": _w((lambda *s: torch.randn(*s, dtype=torch.bfloat16) * 0.05)(B, H, Sk, D)),
    }

def reference(q, k, v):
    scale = q.shape[-1] ** -0.5
    scores = torch.einsum("bhqd,bhkd->bhqk", q, k) * scale
    p = _softmax(scores, axis=-1)
    return torch.einsum("bhqk,bhkd->bhqd", p, v)
```

```asm
; @launch grid=(256,1,1) block=(320,1,1) lds=2112
.amdgcn_target "amdgcn-amd-amdhsa--gfx950"
.text
.p2align 13
.rept 64
    s_endpgm
.endr
.globl standalone__mha_softmax__decode_kernel
.p2align 8
.type standalone__mha_softmax__decode_kernel,@function
standalone__mha_softmax__decode_kernel:
    s_load_dwordx2 s[12:13], s[0:1], 0
    s_load_dwordx2 s[4:5], s[0:1], 8
    s_load_dwordx2 s[8:9], s[0:1], 16
    v_lshrrev_b32 v6, 6, v0
    v_and_b32 v2, 63, v0
    v_readfirstlane_b32 s30, v6
    s_cmp_ge_u32 s2, 256
    s_cbranch_scc1 L_end
    s_and_b32 s46, s2, 7
    s_lshl_b32 s46, s46, 5
    s_lshr_b32 s37, s2, 3
    s_or_b32 s46, s46, s37
    s_lshr_b32 s28, s46, 2
    s_lshl_b32 s32, s28, 8
    s_cmp_eq_u32 s30, 4
    s_cbranch_scc1 L_disp0
    s_and_b32 s34, s37, 0x17
    s_and_b32 s37, s2, 32
    s_add_u32 s34, s34, s37
    s_and_b32 s37, s2, 2
    s_lshl_b32 s37, s37, 2
    s_sub_u32 s34, s34, s37
    s_getreg_b32 s37, hwreg(HW_REG_XCC_ID, 0, 1)
    s_cmp_eq_u32 s37, 1
    s_cselect_b32 s37, 44, 0
    s_cselect_b32 s48, 15, 1
    s_cselect_b32 s49, 4, 3
    s_add_u32 s34, s34, s37
    s_lshl_b32 s34, s34, 14
    s_and_b32 s34, s34, 0xfffff
    s_lshl_b32 s48, s48, 16
    s_lshl_b32 s3, s28, 20
    s_mov_b32 s6, 0x4000000
    s_mov_b32 s7, 0x00020000
    s_mov_b32 s14, 0x4000
    s_mov_b32 s15, 0x00020000
    v_lshl_add_u32 v1, v2, 4, s3
    v_lshl_add_u32 v1, v6, 12, v1
    v_and_b32 v7, 15, v0
    v_lshlrev_b32 v7, 4, v7
    v_lshlrev_b32 v6, 2, v2
    s_waitcnt lgkmcnt(0)
    buffer_load_dword v4, v6, s[12:15], s32 offen nt
    buffer_load_dwordx4 v[44:47], v1, s[4:7], s34 offen offset:0 nt
    buffer_load_dwordx4 v[48:51], v1, s[4:7], s34 offen offset:1024 nt
    buffer_load_dwordx4 v[52:55], v1, s[4:7], s34 offen offset:2048 nt
    buffer_load_dwordx4 v[56:59], v1, s[4:7], s34 offen offset:3072 nt
    s_add_u32 s34, s34, s48
    s_and_b32 s34, s34, 0xfffff
    buffer_load_dwordx4 v[60:63], v1, s[4:7], s34 offen offset:0 nt
    buffer_load_dwordx4 v[64:67], v1, s[4:7], s34 offen offset:1024 nt
    buffer_load_dwordx4 v[68:71], v1, s[4:7], s34 offen offset:2048 nt
    buffer_load_dwordx4 v[72:75], v1, s[4:7], s34 offen offset:3072 nt
    s_add_u32 s34, s34, s48
    s_and_b32 s34, s34, 0xfffff
    s_waitcnt vmcnt(8)
    ds_bpermute_b32 v8, v7, v4 offset:0
    ds_bpermute_b32 v9, v7, v4 offset:4
    ds_bpermute_b32 v10, v7, v4 offset:8
    ds_bpermute_b32 v11, v7, v4 offset:12
    s_waitcnt lgkmcnt(0)
    s_mov_b32 s44, 0x11111111
    s_mov_b32 s45, s44
    s_mov_b32 s47, 0
    s_branch L_kloop
L_disp0:
    s_mul_i32 s47, s37, 52
    s_lshr_b32 s47, s47, 8
    s_mul_i32 s47, s47, 5
    s_sub_u32 s47, s37, s47
    s_mov_b32 s36, 5
L_disp:
    s_sub_u32 s36, s36, 1
    s_cbranch_scc1 L_helper
    s_sub_u32 s47, s47, 1
    s_cselect_b32 s47, 4, s47
    s_cmp_eq_u32 s47, 4
    s_cbranch_scc1 L_touch0
    s_cmp_eq_u32 s47, 3
    s_cbranch_scc1 L_touch1
    s_cmp_eq_u32 s47, 2
    s_cbranch_scc1 L_touch2
    s_cmp_eq_u32 s47, 1
    s_cbranch_scc1 L_touch3
    s_branch L_touch4
L_kloop:
    s_waitcnt vmcnt(7)
    v_dot2_f32_bf16 v28, v44, v8, 0
    v_dot2_f32_bf16 v28, v45, v9, v28
    v_dot2_f32_bf16 v28, v46, v10, v28
    v_dot2_f32_bf16 v28, v47, v11, v28
    s_waitcnt vmcnt(6)
    v_dot2_f32_bf16 v29, v48, v8, 0
    v_dot2_f32_bf16 v29, v49, v9, v29
    v_dot2_f32_bf16 v29, v50, v10, v29
    v_dot2_f32_bf16 v29, v51, v11, v29
    s_waitcnt vmcnt(5)
    v_dot2_f32_bf16 v30, v52, v8, 0
    v_dot2_f32_bf16 v30, v53, v9, v30
    v_dot2_f32_bf16 v30, v54, v10, v30
    v_dot2_f32_bf16 v30, v55, v11, v30
    s_waitcnt vmcnt(4)
    v_dot2_f32_bf16 v31, v56, v8, 0
    v_dot2_f32_bf16 v31, v57, v9, v31
    v_dot2_f32_bf16 v31, v58, v10, v31
    v_dot2_f32_bf16 v31, v59, v11, v31
    buffer_load_dwordx4 v[44:47], v1, s[4:7], s34 offen offset:0 nt
    buffer_load_dwordx4 v[48:51], v1, s[4:7], s34 offen offset:1024 nt
    buffer_load_dwordx4 v[52:55], v1, s[4:7], s34 offen offset:2048 nt
    buffer_load_dwordx4 v[56:59], v1, s[4:7], s34 offen offset:3072 nt
    s_add_u32 s34, s34, s48
    s_and_b32 s34, s34, 0xfffff
    v_add_f32_dpp v28, v28, v28 row_ror:8 row_mask:0xf bank_mask:0x3
    v_add_f32_dpp v30, v30, v30 row_ror:8 row_mask:0xf bank_mask:0x3
    s_nop 0
    v_add_f32_dpp v28, v29, v29 row_ror:8 row_mask:0xf bank_mask:0xc
    v_add_f32_dpp v30, v31, v31 row_ror:8 row_mask:0xf bank_mask:0xc
    s_nop 0
    v_add_f32_dpp v28, v28, v28 row_half_mirror row_mask:0xf bank_mask:0x5
    s_nop 1
    v_add_f32_dpp v28, v30, v30 row_half_mirror row_mask:0xf bank_mask:0xa
    s_waitcnt vmcnt(7)
    v_dot2_f32_bf16 v32, v60, v8, 0
    v_dot2_f32_bf16 v32, v61, v9, v32
    v_dot2_f32_bf16 v32, v62, v10, v32
    v_dot2_f32_bf16 v32, v63, v11, v32
    s_waitcnt vmcnt(6)
    v_dot2_f32_bf16 v33, v64, v8, 0
    v_dot2_f32_bf16 v33, v65, v9, v33
    v_dot2_f32_bf16 v33, v66, v10, v33
    v_dot2_f32_bf16 v33, v67, v11, v33
    s_waitcnt vmcnt(5)
    s_branch L_over0
L_touch0:
    s_branch L_disp
L_over0:
    v_dot2_f32_bf16 v34, v68, v8, 0
    v_dot2_f32_bf16 v34, v69, v9, v34
    v_dot2_f32_bf16 v34, v70, v10, v34
    v_dot2_f32_bf16 v34, v71, v11, v34
    s_waitcnt vmcnt(4)
    v_dot2_f32_bf16 v35, v72, v8, 0
    v_dot2_f32_bf16 v35, v73, v9, v35
    v_dot2_f32_bf16 v35, v74, v10, v35
    v_dot2_f32_bf16 v35, v75, v11, v35
    buffer_load_dwordx4 v[60:63], v1, s[4:7], s34 offen offset:0 nt
    buffer_load_dwordx4 v[64:67], v1, s[4:7], s34 offen offset:1024 nt
    buffer_load_dwordx4 v[68:71], v1, s[4:7], s34 offen offset:2048 nt
    buffer_load_dwordx4 v[72:75], v1, s[4:7], s34 offen offset:3072 nt
    s_add_u32 s34, s34, s48
    s_and_b32 s34, s34, 0xfffff
    v_add_f32_dpp v32, v32, v32 row_ror:8 row_mask:0xf bank_mask:0x3
    v_add_f32_dpp v34, v34, v34 row_ror:8 row_mask:0xf bank_mask:0x3
    s_nop 0
    v_add_f32_dpp v32, v33, v33 row_ror:8 row_mask:0xf bank_mask:0xc
    v_add_f32_dpp v34, v35, v35 row_ror:8 row_mask:0xf bank_mask:0xc
    s_nop 0
    v_add_f32_dpp v32, v32, v32 row_half_mirror row_mask:0xf bank_mask:0x5
    s_nop 1
    v_add_f32_dpp v32, v34, v34 row_half_mirror row_mask:0xf bank_mask:0xa
    s_waitcnt vmcnt(7)
    v_dot2_f32_bf16 v36, v44, v8, 0
    v_dot2_f32_bf16 v36, v45, v9, v36
    v_dot2_f32_bf16 v36, v46, v10, v36
    v_dot2_f32_bf16 v36, v47, v11, v36
    s_waitcnt vmcnt(6)
    v_dot2_f32_bf16 v37, v48, v8, 0
    v_dot2_f32_bf16 v37, v49, v9, v37
    v_dot2_f32_bf16 v37, v50, v10, v37
    v_dot2_f32_bf16 v37, v51, v11, v37
    s_waitcnt vmcnt(5)
    v_dot2_f32_bf16 v38, v52, v8, 0
    v_dot2_f32_bf16 v38, v53, v9, v38
    v_dot2_f32_bf16 v38, v54, v10, v38
    v_dot2_f32_bf16 v38, v55, v11, v38
    s_waitcnt vmcnt(4)
    v_dot2_f32_bf16 v39, v56, v8, 0
    v_dot2_f32_bf16 v39, v57, v9, v39
    v_dot2_f32_bf16 v39, v58, v10, v39
    v_dot2_f32_bf16 v39, v59, v11, v39
    s_cmp_eq_u32 s47, 3
    s_cselect_b64 s[4:5], s[8:9], s[4:5]
    buffer_load_dwordx4 v[44:47], v1, s[4:7], s34 offen offset:0 nt
    buffer_load_dwordx4 v[48:51], v1, s[4:7], s34 offen offset:1024 nt
    buffer_load_dwordx4 v[52:55], v1, s[4:7], s34 offen offset:2048 nt
    buffer_load_dwordx4 v[56:59], v1, s[4:7], s34 offen offset:3072 nt
    s_add_u32 s34, s34, s48
    s_and_b32 s34, s34, 0xfffff
    v_add_f32_dpp v36, v36, v36 row_ror:8 row_mask:0xf bank_mask:0x3
    v_add_f32_dpp v38, v38, v38 row_ror:8 row_mask:0xf bank_mask:0x3
    s_nop 0
    v_add_f32_dpp v36, v37, v37 row_ror:8 row_mask:0xf bank_mask:0xc
    v_add_f32_dpp v38, v39, v39 row_ror:8 row_mask:0xf bank_mask:0xc
    s_nop 0
    v_add_f32_dpp v36, v36, v36 row_half_mirror row_mask:0xf bank_mask:0x5
    s_nop 1
    v_add_f32_dpp v36, v38, v38 row_half_mirror row_mask:0xf bank_mask:0xa
    s_waitcnt vmcnt(7)
    v_dot2_f32_bf16 v40, v60, v8, 0
    v_dot2_f32_bf16 v40, v61, v9, v40
    v_dot2_f32_bf16 v40, v62, v10, v40
    v_dot2_f32_bf16 v40, v63, v11, v40
    s_waitcnt vmcnt(6)
    v_dot2_f32_bf16 v41, v64, v8, 0
    v_dot2_f32_bf16 v41, v65, v9, v41
    v_dot2_f32_bf16 v41, v66, v10, v41
    v_dot2_f32_bf16 v41, v67, v11, v41
    s_waitcnt vmcnt(5)
    v_dot2_f32_bf16 v42, v68, v8, 0
    v_dot2_f32_bf16 v42, v69, v9, v42
    v_dot2_f32_bf16 v42, v70, v10, v42
    v_dot2_f32_bf16 v42, v71, v11, v42
    s_waitcnt vmcnt(4)
    v_dot2_f32_bf16 v43, v72, v8, 0
    v_dot2_f32_bf16 v43, v73, v9, v43
    v_dot2_f32_bf16 v43, v74, v10, v43
    v_dot2_f32_bf16 v43, v75, v11, v43
    buffer_load_dwordx4 v[60:63], v1, s[4:7], s34 offen offset:0 nt
    buffer_load_dwordx4 v[64:67], v1, s[4:7], s34 offen offset:1024 nt
    buffer_load_dwordx4 v[68:71], v1, s[4:7], s34 offen offset:2048 nt
    buffer_load_dwordx4 v[72:75], v1, s[4:7], s34 offen offset:3072 nt
    s_add_u32 s34, s34, s48
    s_and_b32 s34, s34, 0xfffff
    v_add_f32_dpp v40, v40, v40 row_ror:8 row_mask:0xf bank_mask:0x3
    v_add_f32_dpp v42, v42, v42 row_ror:8 row_mask:0xf bank_mask:0x3
    s_nop 0
    v_add_f32_dpp v40, v41, v41 row_ror:8 row_mask:0xf bank_mask:0xc
    v_add_f32_dpp v42, v43, v43 row_ror:8 row_mask:0xf bank_mask:0xc
    s_nop 0
    v_add_f32_dpp v40, v40, v40 row_half_mirror row_mask:0xf bank_mask:0x5
    s_nop 1
    v_add_f32_dpp v40, v42, v42 row_half_mirror row_mask:0xf bank_mask:0xa
    s_add_u32 s47, s47, 1
    v_add_f32_dpp v28, v28, v28 quad_perm:[1,0,3,2] row_mask:0xf bank_mask:0xf
    v_add_f32_dpp v32, v32, v32 quad_perm:[1,0,3,2] row_mask:0xf bank_mask:0xf
    v_add_f32_dpp v36, v36, v36 quad_perm:[1,0,3,2] row_mask:0xf bank_mask:0xf
    v_add_f32_dpp v40, v40, v40 quad_perm:[1,0,3,2] row_mask:0xf bank_mask:0xf
    v_add_f32_dpp v28, v28, v28 quad_perm:[2,3,0,1] row_mask:0xf bank_mask:0xf
    v_add_f32_dpp v32, v32, v32 quad_perm:[2,3,0,1] row_mask:0xf bank_mask:0xf
    v_add_f32_dpp v36, v36, v36 quad_perm:[2,3,0,1] row_mask:0xf bank_mask:0xf
    v_add_f32_dpp v40, v40, v40 quad_perm:[2,3,0,1] row_mask:0xf bank_mask:0xf
    v_cndmask_b32 v20, v20, v28, s[44:45]
    v_cndmask_b32 v21, v21, v32, s[44:45]
    s_branch L_over1
L_touch1:
    s_branch L_disp
L_over1:
    v_cndmask_b32 v22, v22, v36, s[44:45]
    v_cndmask_b32 v23, v23, v40, s[44:45]
    s_lshl_b64 s[44:45], s[44:45], 1
    s_cmp_lt_u32 s47, 4
    s_cbranch_scc1 L_kloop
    v_max_f32 v4, v20, v21
    v_max3_f32 v4, v4, v22, v23
    s_mov_b32 s31, 0x3e0293ee
    v_and_b32 v28, 1, v0
    v_max_f32_dpp v4, v4, v4 row_ror:8 row_mask:0xf bank_mask:0xf
    v_lshlrev_b32 v28, 4, v28
    v_mov_b32 v29, 0xffff
    v_max_f32_dpp v4, v4, v4 row_ror:4 row_mask:0xf bank_mask:0xf
    v_lshlrev_b32 v28, v28, v29
    v_bfe_u32 v29, v0, 1, 3
    v_max_f32_dpp v4, v4, v4 row_ror:2 row_mask:0xf bank_mask:0xf
    v_cmp_eq_u32 s[40:41], 0, v29
    v_cmp_eq_u32 s[42:43], 1, v29
    v_max_f32_dpp v4, v4, v4 row_ror:1 row_mask:0xf bank_mask:0xf
    v_mov_b32 v6, v4
    v_cmp_eq_u32 s[44:45], 2, v29
    v_cmp_eq_u32 vcc, 3, v29
    v_permlane32_swap_b32 v4, v6
    v_cndmask_b32 v12, 0, v28, s[40:41]
    v_max_f32 v4, v4, v6
    v_mov_b32 v6, v4
    v_cndmask_b32 v13, 0, v28, s[42:43]
    v_cndmask_b32 v14, 0, v28, s[44:45]
    v_permlane16_swap_b32 v4, v6
    v_cndmask_b32 v15, 0, v28, vcc
    v_max_f32 v4, v4, v6
    v_sub_f32 v20, v20, v4
    v_sub_f32 v21, v21, v4
    v_sub_f32 v22, v22, v4
    v_sub_f32 v23, v23, v4
    v_mul_f32 v20, s31, v20
    v_mul_f32 v21, s31, v21
    v_mul_f32 v22, s31, v22
    v_mul_f32 v23, s31, v23
    v_exp_f32 v20, v20
    v_exp_f32 v21, v21
    v_exp_f32 v22, v22
    v_exp_f32 v23, v23
    v_add_f32 v5, v20, v21
    v_add_f32 v5, v5, v22
    v_add_f32 v5, v5, v23
    v_cvt_pk_bf16_f32 v20, v20, v20
    v_cvt_pk_bf16_f32 v21, v21, v21
    v_add_f32_dpp v5, v5, v5 row_ror:8 row_mask:0xf bank_mask:0xf
    v_cvt_pk_bf16_f32 v22, v22, v22
    v_cvt_pk_bf16_f32 v23, v23, v23
    v_add_f32_dpp v5, v5, v5 row_ror:4 row_mask:0xf bank_mask:0xf
    v_mov_b32 v16, 0
    v_mov_b32 v17, 0
    v_add_f32_dpp v5, v5, v5 row_ror:2 row_mask:0xf bank_mask:0xf
    v_mov_b32 v18, 0
    v_mov_b32 v19, 0
    v_add_f32_dpp v5, v5, v5 row_ror:1 row_mask:0xf bank_mask:0xf
    v_mov_b32 v6, v5
    s_lshl_b32 s37, s30, 9
    v_lshl_add_u32 v26, v2, 4, s37
    v_permlane32_swap_b32 v5, v6
    s_lshl_b32 s37, s30, 3
    v_add_f32 v5, v5, v6
    v_mov_b32 v6, v5
    v_mov_b32 v7, s37
    s_mov_b32 s47, 0
    v_permlane16_swap_b32 v5, v6
    s_nop 0
    v_add_f32 v5, v5, v6
    ds_write_b64 v7, v[4:5] offset:2048
L_vloop:
    v_and_b32_dpp v28, v20, v12 row_newbcast:0 row_mask:0xf bank_mask:0xf
    v_and_b32_dpp v29, v20, v13 row_newbcast:0 row_mask:0xf bank_mask:0xf
    v_and_b32_dpp v30, v20, v14 row_newbcast:0 row_mask:0xf bank_mask:0xf
    v_and_b32_dpp v31, v20, v15 row_newbcast:0 row_mask:0xf bank_mask:0xf
    v_and_b32_dpp v32, v20, v12 row_newbcast:8 row_mask:0xf bank_mask:0xf
    v_and_b32_dpp v33, v20, v13 row_newbcast:8 row_mask:0xf bank_mask:0xf
    v_and_b32_dpp v34, v20, v14 row_newbcast:8 row_mask:0xf bank_mask:0xf
    v_and_b32_dpp v35, v20, v15 row_newbcast:8 row_mask:0xf bank_mask:0xf
    v_and_b32_dpp v36, v20, v12 row_newbcast:4 row_mask:0xf bank_mask:0xf
    v_and_b32_dpp v37, v20, v13 row_newbcast:4 row_mask:0xf bank_mask:0xf
    v_and_b32_dpp v38, v20, v14 row_newbcast:4 row_mask:0xf bank_mask:0xf
    v_and_b32_dpp v39, v20, v15 row_newbcast:4 row_mask:0xf bank_mask:0xf
    v_and_b32_dpp v40, v20, v12 row_newbcast:12 row_mask:0xf bank_mask:0xf
    v_and_b32_dpp v41, v20, v13 row_newbcast:12 row_mask:0xf bank_mask:0xf
    v_and_b32_dpp v42, v20, v14 row_newbcast:12 row_mask:0xf bank_mask:0xf
    v_and_b32_dpp v43, v20, v15 row_newbcast:12 row_mask:0xf bank_mask:0xf
    s_waitcnt vmcnt(7)
    v_mfma_f32_16x16x32_bf16 v[16:19], v[28:31], v[44:47], v[16:19]
    s_waitcnt vmcnt(6)
    v_mfma_f32_16x16x32_bf16 v[16:19], v[32:35], v[48:51], v[16:19]
    s_waitcnt vmcnt(5)
    v_mfma_f32_16x16x32_bf16 v[16:19], v[36:39], v[52:55], v[16:19]
    s_waitcnt vmcnt(4)
    v_mfma_f32_16x16x32_bf16 v[16:19], v[40:43], v[56:59], v[16:19]
    s_cmp_eq_u32 s47, s49
    s_cbranch_scc0 L_wide0
    s_waitcnt vmcnt(3)
L_wide0:
    buffer_load_dwordx4 v[44:47], v1, s[4:7], s34 offen offset:0 nt
    buffer_load_dwordx4 v[48:51], v1, s[4:7], s34 offen offset:1024 nt
    buffer_load_dwordx4 v[52:55], v1, s[4:7], s34 offen offset:2048 nt
    buffer_load_dwordx4 v[56:59], v1, s[4:7], s34 offen offset:3072 nt
    s_add_u32 s34, s34, s48
    s_and_b32 s34, s34, 0xfffff
    v_mov_b32_dpp v20, v20 quad_perm:[1,2,3,0] row_mask:0xf bank_mask:0xf
    v_and_b32_dpp v28, v21, v12 row_newbcast:0 row_mask:0xf bank_mask:0xf
    v_and_b32_dpp v29, v21, v13 row_newbcast:0 row_mask:0xf bank_mask:0xf
    v_and_b32_dpp v30, v21, v14 row_newbcast:0 row_mask:0xf bank_mask:0xf
    v_and_b32_dpp v31, v21, v15 row_newbcast:0 row_mask:0xf bank_mask:0xf
    v_and_b32_dpp v32, v21, v12 row_newbcast:8 row_mask:0xf bank_mask:0xf
    v_and_b32_dpp v33, v21, v13 row_newbcast:8 row_mask:0xf bank_mask:0xf
    v_and_b32_dpp v34, v21, v14 row_newbcast:8 row_mask:0xf bank_mask:0xf
    v_and_b32_dpp v35, v21, v15 row_newbcast:8 row_mask:0xf bank_mask:0xf
    v_and_b32_dpp v36, v21, v12 row_newbcast:4 row_mask:0xf bank_mask:0xf
    v_and_b32_dpp v37, v21, v13 row_newbcast:4 row_mask:0xf bank_mask:0xf
    v_and_b32_dpp v38, v21, v14 row_newbcast:4 row_mask:0xf bank_mask:0xf
    v_and_b32_dpp v39, v21, v15 row_newbcast:4 row_mask:0xf bank_mask:0xf
    v_and_b32_dpp v40, v21, v12 row_newbcast:12 row_mask:0xf bank_mask:0xf
    v_and_b32_dpp v41, v21, v13 row_newbcast:12 row_mask:0xf bank_mask:0xf
    v_and_b32_dpp v42, v21, v14 row_newbcast:12 row_mask:0xf bank_mask:0xf
    v_and_b32_dpp v43, v21, v15 row_newbcast:12 row_mask:0xf bank_mask:0xf
    s_waitcnt vmcnt(7)
    s_branch L_over2
L_touch2:
    s_branch L_disp
L_over2:
    v_mfma_f32_16x16x32_bf16 v[16:19], v[28:31], v[60:63], v[16:19]
    s_waitcnt vmcnt(6)
    v_mfma_f32_16x16x32_bf16 v[16:19], v[32:35], v[64:67], v[16:19]
    s_waitcnt vmcnt(5)
    v_mfma_f32_16x16x32_bf16 v[16:19], v[36:39], v[68:71], v[16:19]
    s_waitcnt vmcnt(4)
    v_mfma_f32_16x16x32_bf16 v[16:19], v[40:43], v[72:75], v[16:19]
    s_cmp_eq_u32 s47, s49
    s_cbranch_scc0 L_wide
    s_waitcnt vmcnt(3)
L_wide:
    buffer_load_dwordx4 v[60:63], v1, s[4:7], s34 offen offset:0 nt
    buffer_load_dwordx4 v[64:67], v1, s[4:7], s34 offen offset:1024 nt
    buffer_load_dwordx4 v[68:71], v1, s[4:7], s34 offen offset:2048 nt
    buffer_load_dwordx4 v[72:75], v1, s[4:7], s34 offen offset:3072 nt
    s_add_u32 s34, s34, s48
    s_and_b32 s34, s34, 0xfffff
    v_mov_b32_dpp v21, v21 quad_perm:[1,2,3,0] row_mask:0xf bank_mask:0xf
    s_cmp_eq_u32 s47, 0
    s_cbranch_scc0 L_nobar
    s_waitcnt lgkmcnt(0)
    s_barrier
L_nobar:
    v_and_b32_dpp v28, v22, v12 row_newbcast:0 row_mask:0xf bank_mask:0xf
    v_and_b32_dpp v29, v22, v13 row_newbcast:0 row_mask:0xf bank_mask:0xf
    v_and_b32_dpp v30, v22, v14 row_newbcast:0 row_mask:0xf bank_mask:0xf
    v_and_b32_dpp v31, v22, v15 row_newbcast:0 row_mask:0xf bank_mask:0xf
    v_and_b32_dpp v32, v22, v12 row_newbcast:8 row_mask:0xf bank_mask:0xf
    v_and_b32_dpp v33, v22, v13 row_newbcast:8 row_mask:0xf bank_mask:0xf
    v_and_b32_dpp v34, v22, v14 row_newbcast:8 row_mask:0xf bank_mask:0xf
    v_and_b32_dpp v35, v22, v15 row_newbcast:8 row_mask:0xf bank_mask:0xf
    v_and_b32_dpp v36, v22, v12 row_newbcast:4 row_mask:0xf bank_mask:0xf
    v_and_b32_dpp v37, v22, v13 row_newbcast:4 row_mask:0xf bank_mask:0xf
    v_and_b32_dpp v38, v22, v14 row_newbcast:4 row_mask:0xf bank_mask:0xf
    v_and_b32_dpp v39, v22, v15 row_newbcast:4 row_mask:0xf bank_mask:0xf
    v_and_b32_dpp v40, v22, v12 row_newbcast:12 row_mask:0xf bank_mask:0xf
    v_and_b32_dpp v41, v22, v13 row_newbcast:12 row_mask:0xf bank_mask:0xf
    v_and_b32_dpp v42, v22, v14 row_newbcast:12 row_mask:0xf bank_mask:0xf
    v_and_b32_dpp v43, v22, v15 row_newbcast:12 row_mask:0xf bank_mask:0xf
    s_waitcnt vmcnt(7)
    v_mfma_f32_16x16x32_bf16 v[16:19], v[28:31], v[44:47], v[16:19]
    s_waitcnt vmcnt(6)
    v_mfma_f32_16x16x32_bf16 v[16:19], v[32:35], v[48:51], v[16:19]
    s_waitcnt vmcnt(5)
    v_mfma_f32_16x16x32_bf16 v[16:19], v[36:39], v[52:55], v[16:19]
    s_waitcnt vmcnt(4)
    v_mfma_f32_16x16x32_bf16 v[16:19], v[40:43], v[56:59], v[16:19]
    s_cmp_eq_u32 s47, 3
    s_cbranch_scc1 L_noload
    buffer_load_dwordx4 v[44:47], v1, s[4:7], s34 offen offset:0 nt
    buffer_load_dwordx4 v[48:51], v1, s[4:7], s34 offen offset:1024 nt
    buffer_load_dwordx4 v[52:55], v1, s[4:7], s34 offen offset:2048 nt
    buffer_load_dwordx4 v[56:59], v1, s[4:7], s34 offen offset:3072 nt
    s_add_u32 s34, s34, s48
    s_and_b32 s34, s34, 0xfffff
L_noload:
    v_mov_b32_dpp v22, v22 quad_perm:[1,2,3,0] row_mask:0xf bank_mask:0xf
    v_and_b32_dpp v28, v23, v12 row_newbcast:0 row_mask:0xf bank_mask:0xf
    v_and_b32_dpp v29, v23, v13 row_newbcast:0 row_mask:0xf bank_mask:0xf
    v_and_b32_dpp v30, v23, v14 row_newbcast:0 row_mask:0xf bank_mask:0xf
    v_and_b32_dpp v31, v23, v15 row_newbcast:0 row_mask:0xf bank_mask:0xf
    v_and_b32_dpp v32, v23, v12 row_newbcast:8 row_mask:0xf bank_mask:0xf
    v_and_b32_dpp v33, v23, v13 row_newbcast:8 row_mask:0xf bank_mask:0xf
    v_and_b32_dpp v34, v23, v14 row_newbcast:8 row_mask:0xf bank_mask:0xf
    v_and_b32_dpp v35, v23, v15 row_newbcast:8 row_mask:0xf bank_mask:0xf
    v_and_b32_dpp v36, v23, v12 row_newbcast:4 row_mask:0xf bank_mask:0xf
    v_and_b32_dpp v37, v23, v13 row_newbcast:4 row_mask:0xf bank_mask:0xf
    v_and_b32_dpp v38, v23, v14 row_newbcast:4 row_mask:0xf bank_mask:0xf
    v_and_b32_dpp v39, v23, v15 row_newbcast:4 row_mask:0xf bank_mask:0xf
    v_and_b32_dpp v40, v23, v12 row_newbcast:12 row_mask:0xf bank_mask:0xf
    v_and_b32_dpp v41, v23, v13 row_newbcast:12 row_mask:0xf bank_mask:0xf
    v_and_b32_dpp v42, v23, v14 row_newbcast:12 row_mask:0xf bank_mask:0xf
    v_and_b32_dpp v43, v23, v15 row_newbcast:12 row_mask:0xf bank_mask:0xf
    s_cmp_eq_u32 s47, 3
    s_cbranch_scc1 L_vlast
    s_waitcnt vmcnt(7)
    v_mfma_f32_16x16x32_bf16 v[16:19], v[28:31], v[60:63], v[16:19]
    s_waitcnt vmcnt(6)
    v_mfma_f32_16x16x32_bf16 v[16:19], v[32:35], v[64:67], v[16:19]
    s_waitcnt vmcnt(5)
    v_mfma_f32_16x16x32_bf16 v[16:19], v[36:39], v[68:71], v[16:19]
    s_waitcnt vmcnt(4)
    v_mfma_f32_16x16x32_bf16 v[16:19], v[40:43], v[72:75], v[16:19]
    buffer_load_dwordx4 v[60:63], v1, s[4:7], s34 offen offset:0 nt
    buffer_load_dwordx4 v[64:67], v1, s[4:7], s34 offen offset:1024 nt
    buffer_load_dwordx4 v[68:71], v1, s[4:7], s34 offen offset:2048 nt
    buffer_load_dwordx4 v[72:75], v1, s[4:7], s34 offen offset:3072 nt
    s_add_u32 s34, s34, s48
    s_and_b32 s34, s34, 0xfffff
    v_mov_b32_dpp v23, v23 quad_perm:[1,2,3,0] row_mask:0xf bank_mask:0xf
    s_add_u32 s47, s47, 1
    s_branch L_vloop
L_vlast:
    s_waitcnt vmcnt(3)
    v_mfma_f32_16x16x32_bf16 v[16:19], v[28:31], v[60:63], v[16:19]
    s_waitcnt vmcnt(2)
    v_mfma_f32_16x16x32_bf16 v[16:19], v[32:35], v[64:67], v[16:19]
    s_waitcnt vmcnt(1)
    v_mfma_f32_16x16x32_bf16 v[16:19], v[36:39], v[68:71], v[16:19]
    s_waitcnt vmcnt(0)
    v_mfma_f32_16x16x32_bf16 v[16:19], v[40:43], v[72:75], v[16:19]
    s_mov_b32 exec_hi, 0
    s_nop 6
    ds_write_b128 v26, v[16:19]
    s_waitcnt lgkmcnt(0)
    s_barrier
    s_endpgm
L_helper:
    s_load_dwordx2 s[24:25], s[0:1], 40
    s_load_dwordx2 s[20:21], s[0:1], 32
    s_load_dwordx2 s[16:17], s[0:1], 24
    s_mov_b32 s18, 0x4000
    s_mov_b32 s19, 0x00020000
    s_mov_b32 s22, 0x100
    s_mov_b32 s23, 0x00020000
    s_mov_b32 s26, 0x10000000
    s_mov_b32 s27, 0x00020000
    s_getreg_b32 s33, hwreg(HW_REG_XCC_ID, 0, 4)
    s_or_b32 s33, s33, 0x80
    s_branch L_over3
L_touch3:
    s_branch L_disp
L_over3:
    s_mov_b32 s31, 0x3e0293ee
    s_lshl_b32 s35, s28, 2
    s_and_b32 s38, s46, 7
    s_lshr_b32 s37, s46, 4
    s_and_b32 s37, s37, 8
    s_or_b32 s38, s38, s37
    s_and_b32 s37, s46, 120
    s_lshl_b32 s37, s37, 1
    s_or_b32 s38, s38, s37
    s_lshl_b32 s38, s38, 10
    v_lshlrev_b32 v24, 4, v2
    v_mov_b32 v6, 0
    s_and_b32 s29, s46, 3
    s_cbranch_scc0 L_consumer
    s_andn2_b32 s40, s38, 0xc00
    s_mov_b32 s36, 6
    s_waitcnt lgkmcnt(0)
    buffer_load_dword v25, v6, s[24:27], s40 offen sc1
    s_waitcnt vmcnt(0)
    v_readfirstlane_b32 s39, v25
    s_barrier
    ds_read_b128 v[8:11], v6 offset:2048
    ds_read_b128 v[12:15], v6 offset:2064
    s_waitcnt lgkmcnt(0)
    v_max_f32 v4, v8, v10
    v_max3_f32 v4, v4, v12, v14
    v_sub_f32 v8, v8, v4
    v_sub_f32 v10, v10, v4
    v_sub_f32 v12, v12, v4
    v_sub_f32 v14, v14, v4
    v_mul_f32 v8, s31, v8
    v_mul_f32 v10, s31, v10
    v_mul_f32 v12, s31, v12
    v_mul_f32 v14, s31, v14
    v_exp_f32 v8, v8
    v_exp_f32 v10, v10
    v_exp_f32 v12, v12
    v_exp_f32 v14, v14
    v_mul_f32 v5, v8, v9
    v_fmac_f32 v5, v10, v11
    v_fmac_f32 v5, v12, v13
    v_fmac_f32 v5, v14, v15
L_beat:
    buffer_load_dword v25, v6, s[24:27], s40 offen sc1
    s_waitcnt vmcnt(0)
    v_readfirstlane_b32 s37, v25
    s_cmp_lg_u32 s37, s39
    s_cbranch_scc1 L_seen
    s_sub_u32 s36, s36, 1
    s_cbranch_scc0 L_beat
    s_mov_b32 s37, 0
L_seen:
    v_min_u32 v4, -2, v4
    v_min_u32 v5, -2, v5
    s_and_b32 s37, s37, 0xff
    s_mov_b64 exec, 1
    s_cmp_eq_u32 s37, s33
    s_cbranch_scc0 L_far
    buffer_store_dwordx2 v[4:5], v6, s[24:27], s38 offen offset:512
    s_mov_b32 exec_lo, -1
    s_barrier
    ds_read_b128 v[28:31], v24 offset:0
    ds_read_b128 v[32:35], v24 offset:512
    ds_read_b128 v[36:39], v24 offset:1024
    ds_read_b128 v[40:43], v24 offset:1536
    s_waitcnt lgkmcnt(3)
    v_pk_mul_f32 v[16:17], v[28:29], v[8:9] op_sel_hi:[1,0]
    v_pk_mul_f32 v[18:19], v[30:31], v[8:9] op_sel_hi:[1,0]
    s_waitcnt lgkmcnt(2)
    v_pk_fma_f32 v[16:17], v[32:33], v[10:11], v[16:17] op_sel_hi:[1,0,1]
    v_pk_fma_f32 v[18:19], v[34:35], v[10:11], v[18:19] op_sel_hi:[1,0,1]
    s_waitcnt lgkmcnt(1)
    v_pk_fma_f32 v[16:17], v[36:37], v[12:13], v[16:17] op_sel_hi:[1,0,1]
    v_pk_fma_f32 v[18:19], v[38:39], v[12:13], v[18:19] op_sel_hi:[1,0,1]
    s_waitcnt lgkmcnt(0)
    v_pk_fma_f32 v[16:17], v[40:41], v[14:15], v[16:17] op_sel_hi:[1,0,1]
    v_pk_fma_f32 v[18:19], v[42:43], v[14:15], v[18:19] op_sel_hi:[1,0,1]
    v_min_u32 v16, -2, v16
    v_min_u32 v17, -2, v17
    v_min_u32 v18, -2, v18
    v_min_u32 v19, -2, v19
    buffer_store_dwordx4 v[16:19], v24, s[24:27], s38 offen
    s_endpgm
L_consumer:
    v_mov_b32 v16, -1
    v_mov_b32 v17, -1
    v_mov_b32 v18, -1
    v_mov_b32 v19, -1
    s_mov_b32 s36, 0x40000
    s_mov_b32 exec_hi, 0xff
    s_waitcnt lgkmcnt(0)
    buffer_load_dword v25, v6, s[24:27], s38 offen sc1
    buffer_store_dwordx4 v[16:19], v24, s[24:27], s38 offen offset:1024
    buffer_store_dwordx4 v[16:19], v24, s[24:27], s38 offen offset:2048
    buffer_store_dwordx4 v[16:19], v24, s[24:27], s38 offen offset:3072
    v_and_b32 v44, 15, v2
    v_lshrrev_b32 v7, 4, v2
    v_lshlrev_b32 v44, 4, v44
    v_lshl_add_u32 v26, v7, 3, v44
    s_mov_b64 exec, 1
    s_waitcnt vmcnt(0)
    v_and_b32 v1, 0xffffff00, v25
    v_or_b32 v1, s33, v1
    v_add_u32 v1, 0x100, v1
    buffer_store_dword v1, v6, s[24:27], s38 offen
    s_mov_b32 exec_lo, -1
    s_add_u32 s40, s38, 0x40000
    s_mov_b32 s37, 0
    s_barrier
    ds_read_b128 v[8:11], v6 offset:2048
    ds_read_b128 v[12:15], v6 offset:2064
    s_waitcnt lgkmcnt(0)
    v_max_f32 v4, v8, v10
    v_max3_f32 v4, v4, v12, v14
    v_sub_f32 v8, v8, v4
    v_sub_f32 v10, v10, v4
    v_sub_f32 v12, v12, v4
    v_sub_f32 v14, v14, v4
    v_mul_f32 v8, s31, v8
    v_mul_f32 v10, s31, v10
    v_mul_f32 v12, s31, v12
    v_mul_f32 v14, s31, v14
    v_exp_f32 v8, v8
    v_exp_f32 v10, v10
    v_exp_f32 v12, v12
    v_exp_f32 v14, v14
    v_mul_f32 v5, v8, v9
    v_fmac_f32 v5, v10, v11
    v_fmac_f32 v5, v12, v13
    v_fmac_f32 v5, v14, v15
L_ml:
    s_mov_b32 exec_lo, 1
    v_add_u32 v1, 0x100, v1
    buffer_store_dword v1, v6, s[24:27], s38 offen
    s_mov_b32 exec_lo, -1
    s_bitcmp1_b32 s37, 1
    s_cselect_b32 s41, s40, s38
    s_bitcmp1_b32 s37, 2
    s_cselect_b32 s42, s40, s38
    s_bitcmp1_b32 s37, 3
    s_cselect_b32 s43, s40, s38
    buffer_load_dwordx2 v[46:47], v6, s[24:27], s41 offen offset:1536 sc1
    buffer_load_dwordx2 v[48:49], v6, s[24:27], s42 offen offset:2560 sc1
    buffer_load_dwordx2 v[50:51], v6, s[24:27], s43 offen offset:3584 sc1
    v_mov_b32 v25, 0
    s_cmp_gt_u32 s36, 0x3fffa
    s_cbranch_scc1 L_nodbg
    buffer_load_dword v25, v6, s[20:23], s35 offen sc1
L_nodbg:
    s_sub_u32 s36, s36, 1
    s_branch L_over4
L_touch4:
    s_branch L_disp
L_over4:
    s_waitcnt vmcnt(0)
    s_cbranch_scc1 L_mlok
    v_readfirstlane_b32 s37, v25
    v_max3_u32 v7, v46, v47, v48
    v_max3_u32 v7, v7, v49, v50
    v_max_u32 v7, v7, v51
    v_cmp_eq_u32 vcc, -1, v7
    s_cbranch_vccnz L_ml
L_mlok:
    v_max_f32 v7, v4, v46
    v_max3_f32 v7, v7, v48, v50
    v_sub_f32 v44, v4, v7
    v_sub_f32 v46, v46, v7
    v_sub_f32 v48, v48, v7
    v_sub_f32 v50, v50, v7
    v_mul_f32 v44, s31, v44
    v_mul_f32 v46, s31, v46
    v_mul_f32 v48, s31, v48
    v_mul_f32 v50, s31, v50
    v_exp_f32 v44, v44
    v_exp_f32 v46, v46
    v_exp_f32 v48, v48
    v_exp_f32 v50, v50
    v_mul_f32 v5, v44, v5
    v_fmac_f32 v5, v46, v47
    v_fmac_f32 v5, v48, v49
    v_fmac_f32 v5, v50, v51
    v_rcp_f32 v5, v5
    s_mov_b32 s36, 0x40000
    v_mul_f32 v44, v44, v5
    v_mul_f32 v46, v46, v5
    v_mul_f32 v48, v48, v5
    v_mul_f32 v50, v50, v5
    v_mul_f32 v8, v8, v44
    v_mul_f32 v10, v10, v44
    v_mul_f32 v12, v12, v44
    v_mul_f32 v14, v14, v44
    buffer_load_dwordx4 v[52:55], v24, s[24:27], s41 offen offset:1024 sc1
    buffer_load_dwordx4 v[56:59], v24, s[24:27], s42 offen offset:2048 sc1
    buffer_load_dwordx4 v[60:63], v24, s[24:27], s43 offen offset:3072 sc1
    s_waitcnt vmcnt(0)
    s_barrier
    buffer_load_dwordx4 v[52:55], v24, s[24:27], s41 offen offset:1024 sc1
    buffer_load_dwordx4 v[56:59], v24, s[24:27], s42 offen offset:2048 sc1
    buffer_load_dwordx4 v[60:63], v24, s[24:27], s43 offen offset:3072 sc1
    ds_read_b128 v[28:31], v24 offset:0
    ds_read_b128 v[32:35], v24 offset:512
    ds_read_b128 v[36:39], v24 offset:1024
    ds_read_b128 v[40:43], v24 offset:1536
    s_waitcnt lgkmcnt(3)
    v_pk_mul_f32 v[16:17], v[28:29], v[8:9] op_sel_hi:[1,0]
    v_pk_mul_f32 v[18:19], v[30:31], v[8:9] op_sel_hi:[1,0]
    s_waitcnt lgkmcnt(2)
    v_pk_fma_f32 v[16:17], v[32:33], v[10:11], v[16:17] op_sel_hi:[1,0,1]
    v_pk_fma_f32 v[18:19], v[34:35], v[10:11], v[18:19] op_sel_hi:[1,0,1]
    s_waitcnt lgkmcnt(1)
    v_pk_fma_f32 v[16:17], v[36:37], v[12:13], v[16:17] op_sel_hi:[1,0,1]
    v_pk_fma_f32 v[18:19], v[38:39], v[12:13], v[18:19] op_sel_hi:[1,0,1]
    s_waitcnt lgkmcnt(0)
    v_pk_fma_f32 v[16:17], v[40:41], v[14:15], v[16:17] op_sel_hi:[1,0,1]
    v_pk_fma_f32 v[18:19], v[42:43], v[14:15], v[18:19] op_sel_hi:[1,0,1]
    buffer_load_dwordx4 v[64:67], v24, s[24:27], s41 offen offset:1024 sc1
    buffer_load_dwordx4 v[68:71], v24, s[24:27], s42 offen offset:2048 sc1
    buffer_load_dwordx4 v[72:75], v24, s[24:27], s43 offen offset:3072 sc1
L_poll:
    s_waitcnt vmcnt(5)
    v_pk_fma_f32 v[20:21], v[52:53], v[46:47], v[16:17] op_sel_hi:[1,0,1]
    v_pk_fma_f32 v[22:23], v[54:55], v[46:47], v[18:19] op_sel_hi:[1,0,1]
    v_max_u32 v7, v52, v53
    v_max3_u32 v7, v7, v54, v55
    s_waitcnt vmcnt(4)
    v_pk_fma_f32 v[20:21], v[56:57], v[48:49], v[20:21] op_sel_hi:[1,0,1]
    v_pk_fma_f32 v[22:23], v[58:59], v[48:49], v[22:23] op_sel_hi:[1,0,1]
    v_max3_u32 v7, v7, v56, v57
    v_max3_u32 v7, v7, v58, v59
    s_waitcnt vmcnt(3)
    v_pk_fma_f32 v[20:21], v[60:61], v[50:51], v[20:21] op_sel_hi:[1,0,1]
    v_pk_fma_f32 v[22:23], v[62:63], v[50:51], v[22:23] op_sel_hi:[1,0,1]
    v_max3_u32 v7, v7, v60, v61
    v_max3_u32 v7, v7, v62, v63
    v_cmp_eq_u32 vcc, -1, v7
    v_cvt_pk_bf16_f32 v20, v20, v21
    v_cvt_pk_bf16_f32 v21, v22, v23
    s_cbranch_vccz L_got
    buffer_load_dwordx4 v[52:55], v24, s[24:27], s41 offen offset:1024 sc1
    buffer_load_dwordx4 v[56:59], v24, s[24:27], s42 offen offset:2048 sc1
    buffer_load_dwordx4 v[60:63], v24, s[24:27], s43 offen offset:3072 sc1
    s_waitcnt vmcnt(5)
    v_pk_fma_f32 v[20:21], v[64:65], v[46:47], v[16:17] op_sel_hi:[1,0,1]
    v_pk_fma_f32 v[22:23], v[66:67], v[46:47], v[18:19] op_sel_hi:[1,0,1]
    v_max_u32 v7, v64, v65
    v_max3_u32 v7, v7, v66, v67
    s_waitcnt vmcnt(4)
    v_pk_fma_f32 v[20:21], v[68:69], v[48:49], v[20:21] op_sel_hi:[1,0,1]
    v_pk_fma_f32 v[22:23], v[70:71], v[48:49], v[22:23] op_sel_hi:[1,0,1]
    v_max3_u32 v7, v7, v68, v69
    v_max3_u32 v7, v7, v70, v71
    s_waitcnt vmcnt(3)
    v_pk_fma_f32 v[20:21], v[72:73], v[50:51], v[20:21] op_sel_hi:[1,0,1]
    v_pk_fma_f32 v[22:23], v[74:75], v[50:51], v[22:23] op_sel_hi:[1,0,1]
    v_max3_u32 v7, v7, v72, v73
    v_max3_u32 v7, v7, v74, v75
    v_cmp_eq_u32 vcc, -1, v7
    v_cvt_pk_bf16_f32 v20, v20, v21
    v_cvt_pk_bf16_f32 v21, v22, v23
    s_cbranch_vccz L_got
    buffer_load_dwordx4 v[64:67], v24, s[24:27], s41 offen offset:1024 sc1
    buffer_load_dwordx4 v[68:71], v24, s[24:27], s42 offen offset:2048 sc1
    buffer_load_dwordx4 v[72:75], v24, s[24:27], s43 offen offset:3072 sc1
    s_sub_u32 s36, s36, 1
    s_cbranch_scc0 L_poll
L_got:
    buffer_store_dwordx2 v[20:21], v26, s[16:19], s32 offen
L_end:
    s_endpgm
L_far:
    s_add_u32 s38, s38, 0x40000
    buffer_store_dwordx2 v[4:5], v6, s[24:27], s38 offen offset:512 sc1
    s_mov_b32 exec_lo, -1
    v_mov_b32 v16, -1
    v_mov_b32 v17, -1
    v_mov_b32 v18, -1
    v_mov_b32 v19, -1
    s_lshl_b32 s37, 1, s29
    v_mov_b32 v25, s37
    buffer_store_dwordx4 v[16:19], v24, s[24:27], s38 offen sc1
    s_mov_b64 exec, 1
    s_waitcnt vmcnt(0)
    buffer_atomic_or v25, v6, s[20:23], s35 offen sc1
    s_mov_b32 exec_lo, -1
    s_barrier
    ds_read_b128 v[28:31], v24 offset:0
    ds_read_b128 v[32:35], v24 offset:512
    ds_read_b128 v[36:39], v24 offset:1024
    ds_read_b128 v[40:43], v24 offset:1536
    s_waitcnt lgkmcnt(3)
    v_pk_mul_f32 v[16:17], v[28:29], v[8:9] op_sel_hi:[1,0]
    v_pk_mul_f32 v[18:19], v[30:31], v[8:9] op_sel_hi:[1,0]
    s_waitcnt lgkmcnt(2)
    v_pk_fma_f32 v[16:17], v[32:33], v[10:11], v[16:17] op_sel_hi:[1,0,1]
    v_pk_fma_f32 v[18:19], v[34:35], v[10:11], v[18:19] op_sel_hi:[1,0,1]
    s_waitcnt lgkmcnt(1)
    v_pk_fma_f32 v[16:17], v[36:37], v[12:13], v[16:17] op_sel_hi:[1,0,1]
    v_pk_fma_f32 v[18:19], v[38:39], v[12:13], v[18:19] op_sel_hi:[1,0,1]
    s_waitcnt lgkmcnt(0)
    v_pk_fma_f32 v[16:17], v[40:41], v[14:15], v[16:17] op_sel_hi:[1,0,1]
    v_pk_fma_f32 v[18:19], v[42:43], v[14:15], v[18:19] op_sel_hi:[1,0,1]
    v_min_u32 v16, -2, v16
    v_min_u32 v17, -2, v17
    v_min_u32 v18, -2, v18
    v_min_u32 v19, -2, v19
    buffer_store_dwordx4 v[16:19], v24, s[24:27], s38 offen sc1
    s_endpgm
.section .rodata,"a"
.p2align 6
.amdhsa_kernel standalone__mha_softmax__decode_kernel
  .amdhsa_next_free_vgpr 76
  .amdhsa_next_free_sgpr 50
  .amdhsa_accum_offset 76
  .amdhsa_group_segment_fixed_size 0
  .amdhsa_kernarg_size 48
  .amdhsa_user_sgpr_count 2
  .amdhsa_user_sgpr_kernarg_segment_ptr 1
  .amdhsa_system_sgpr_workgroup_id_x 1
.end_amdhsa_kernel
```
